```python
import torch

def _softmax(x, axis=-1):
    return torch.softmax(x, dim=axis)
def _gelu(x):
    return torch.nn.functional.gelu(x, approximate="tanh")
def _silu(x):
    return torch.nn.functional.silu(x)
def _sigmoid(x):
    return torch.sigmoid(x)
def _layernorm(x, axis=-1, eps=1e-5):
    m = x.mean(dim=axis, keepdim=True)
    v = x.var(dim=axis, keepdim=True, unbiased=False)
    return (x - m) / torch.sqrt(v + eps)
def _scatter_add(tgt, idx, src, axis=0):
    return tgt.clone().index_add_(axis, idx, src)
def _segment_sum(src, seg, n):
    out = torch.zeros((n,) + src.shape[1:], dtype=src.dtype)
    return out.index_add_(0, seg, src)
def _pad(x, pw):
    flat = tuple(v for pair in reversed(pw) for v in pair)
    return torch.nn.functional.pad(x, flat)

kernel_name = 'standalone__fm_second_order__recsys'

def setup_inputs():

    _w = (lambda a: (lambda t: t.to(torch.bfloat16) if t.is_floating_point() else t)(torch.as_tensor(a)))
    B, F, D, V = 16384, 26, 128, min(100000, 100000)
    return {
        "idx": _w((lambda lo, hi, *s: torch.randint(lo, hi, s))(0, V, B, F).to(torch.int64)),
        "table": _w((lambda *s: torch.randn(*s, dtype=torch.bfloat16) * 0.05)(V, D)),
    }

def reference(idx, table):
    emb = table[idx]
    sum_sq = emb.sum(axis=1) ** 2
    sq_sum = (emb ** 2).sum(axis=1)
    return 0.5 * (sum_sq - sq_sum).sum(axis=-1)
```

```asm
; @launch grid=(520,1,1) block=(512,1,1) lds=8192
.amdgcn_target "amdgcn-amd-amdhsa--gfx950"
.text
.globl standalone__fm_second_order__recsys_kernel
.p2align 8
.type standalone__fm_second_order__recsys_kernel,@function
standalone__fm_second_order__recsys_kernel:
    s_cmp_ge_u32 s2, 520
    s_cbranch_scc1 L_end
    s_cmp_lt_u32 s2, 8
    s_cbranch_scc1 L_helper
    s_load_dwordx4 s[4:7], s[0:1], 0
    s_load_dwordx4 s[36:39], s[0:1], 16
    s_load_dwordx2 s[28:29], s[0:1], 32
    s_and_b32 s21, s2, 7
    s_lshr_b32 s22, s2, 3
    s_sub_u32 s22, s22, 1
    s_lshr_b32 s23, s21, 2
    s_and_b32 s21, s21, 3
    s_lshl_b32 s22, s22, 2
    s_add_u32 s22, s22, s21
    v_and_b32 v1, 63, v0
    v_lshrrev_b32 v5, 6, v0
    s_mul_i32 s3, s22, 6656
    v_mul_u32_u24 v6, 832, v5
    v_readfirstlane_b32 s34, v5
    v_lshl_add_u32 v6, v1, 3, v6
    v_add_u32 v6, s3, v6
    s_mov_b32 s10, 1703936
    s_mov_b32 s11, 0x00020000
    v_and_b32 v2, 15, v0
    v_lshrrev_b32 v3, 5, v1
    v_bfe_u32 v4, v1, 4, 1
    v_lshrrev_b32 v7, 3, v2
    v_lshl_add_u32 v7, v3, 1, v7
    v_lshlrev_b32 v61, 10, v5
    v_mul_u32_u24 v60, 104, v7
    v_mul_u32_u24 v4, 52, v4
    v_add3_u32 v60, v60, v4, v61
    v_lshl_add_u32 v61, v1, 3, v61
    s_waitcnt lgkmcnt(0)
    s_mov_b32 s8, s4
    s_and_b32 s9, s5, 0xffff
    buffer_load_dwordx2 v[56:57], v6, s[8:11], 0 offen offset:0
    buffer_load_dwordx2 v[58:59], v6, s[8:11], 0 offen offset:512
    s_mov_b32 s20, 0xffff0000
    s_mov_b32 s12, s6
    s_and_b32 s13, s7, 0xffff
    s_mov_b32 s14, 25600000
    s_mov_b32 s15, 0x00020000
    s_and_b32 s29, s29, 0xffff
    s_mov_b32 s30, 131072
    s_mov_b32 s31, 0x00020000
    s_mov_b32 s16, s36
    s_and_b32 s17, s37, 0xffff
    s_mov_b32 s18, 32768
    s_mov_b32 s19, 0x00020000
    s_mov_b32 s24, s38
    s_and_b32 s25, s39, 0xffff
    s_mov_b32 s26, 256
    s_mov_b32 s27, 0x00020000
    v_lshrrev_b32 v7, 3, v2
    v_cmp_eq_u32 vcc, v7, v3
    v_and_b32 v4, 1, v2
    v_lshlrev_b32 v4, 4, v4
    v_mov_b32 v7, 0x3f80
    v_lshlrev_b32 v7, v4, v7
    v_cndmask_b32 v7, 0, v7, vcc
    v_bfe_u32 v4, v2, 1, 2
    v_cmp_eq_u32 vcc, 0, v4
    s_nop 1
    v_cndmask_b32 v8, 0, v7, vcc
    v_cmp_eq_u32 vcc, 1, v4
    s_nop 1
    v_cndmask_b32 v9, 0, v7, vcc
    v_cmp_eq_u32 vcc, 2, v4
    s_nop 1
    v_cndmask_b32 v10, 0, v7, vcc
    v_cmp_eq_u32 vcc, 3, v4
    s_nop 1
    v_cndmask_b32 v11, 0, v7, vcc
    s_mul_i32 s3, s22, 64
    v_lshl_add_u32 v5, v5, 3, s3
    v_and_b32 v4, 3, v2
    v_lshl_add_u32 v5, v4, 1, v5
    v_add_u32 v1, v5, v3
    v_lshrrev_b32 v6, 8, v1
    v_lshlrev_b32 v6, 2, v6
    v_and_b32 v7, 7, v2
    v_lshlrev_b32 v7, 4, v7
    s_lshl_b32 s3, s23, 7
    v_add_u32 v7, s3, v7
    s_cmp_lg_u32 s23, 0
    s_cselect_b64 s[32:33], -1, 0
    s_waitcnt vmcnt(1)
    ds_write_b64 v61, v[56:57] offset:0
    s_waitcnt vmcnt(0)
    ds_write_b64 v61, v[58:59] offset:512
    ds_read2_b32 v[28:29], v60 offset0:0 offset1:1
    ds_read2_b32 v[30:31], v60 offset0:2 offset1:3
    ds_read2_b32 v[32:33], v60 offset0:4 offset1:5
    ds_read2_b32 v[34:35], v60 offset0:6 offset1:7
    ds_read2_b32 v[36:37], v60 offset0:8 offset1:9
    ds_read2_b32 v[38:39], v60 offset0:10 offset1:11
    ds_read_b32 v40, v60 offset:48
    ds_read2_b32 v[42:43], v60 offset0:104 offset1:105
    ds_read2_b32 v[44:45], v60 offset0:106 offset1:107
    ds_read2_b32 v[46:47], v60 offset0:108 offset1:109
    ds_read2_b32 v[48:49], v60 offset0:110 offset1:111
    ds_read2_b32 v[50:51], v60 offset0:112 offset1:113
    ds_read2_b32 v[52:53], v60 offset0:114 offset1:115
    ds_read_b32 v54, v60 offset:464
    s_waitcnt lgkmcnt(7)
    v_med3_u32 v41, v28, v39, v38
    v_max3_u32 v55, v28, v39, v38
    v_min3_u32 v28, v28, v39, v38
    v_med3_u32 v39, v35, v37, v30
    v_max3_u32 v38, v35, v37, v30
    v_min3_u32 v35, v35, v37, v30
    v_med3_u32 v37, v33, v34, v32
    v_max3_u32 v30, v33, v34, v32
    v_min3_u32 v33, v33, v34, v32
    v_med3_u32 v34, v29, v31, v36
    v_max3_u32 v32, v29, v31, v36
    v_min3_u32 v29, v29, v31, v36
    v_med3_u32 v31, v39, v40, v41
    v_max3_u32 v36, v39, v40, v41
    v_min3_u32 v39, v39, v40, v41
    v_med3_u32 v40, v37, v31, v34
    v_max3_u32 v41, v37, v31, v34
    v_min3_u32 v37, v37, v31, v34
    v_med3_u32 v31, v28, v33, v29
    v_max3_u32 v34, v28, v33, v29
    v_min3_u32 v28, v28, v33, v29
    v_med3_u32 v33, v35, v39, v34
    v_max3_u32 v29, v35, v39, v34
    v_min3_u32 v35, v35, v39, v34
    v_med3_u32 v39, v31, v33, v37
    v_max3_u32 v34, v31, v33, v37
    v_min3_u32 v31, v31, v33, v37
    v_med3_u32 v33, v28, v35, v31
    v_max3_u32 v37, v28, v35, v31
    v_min3_u32 v28, v28, v35, v31
    v_lshl_add_u32 v56, v28, 8, v7
    buffer_load_dwordx4 v[56:59], v56, s[12:15], 0 offen
    v_lshl_add_u32 v60, v33, 8, v7
    buffer_load_dwordx4 v[60:63], v60, s[12:15], 0 offen
    v_med3_u32 v35, v38, v55, v30
    v_max3_u32 v31, v38, v55, v30
    v_min3_u32 v38, v38, v55, v30
    v_med3_u32 v55, v38, v36, v32
    v_max3_u32 v30, v38, v36, v32
    v_min3_u32 v38, v38, v36, v32
    v_med3_u32 v36, v29, v40, v38
    v_max3_u32 v32, v29, v40, v38
    v_min3_u32 v29, v29, v40, v38
    v_med3_u32 v40, v41, v55, v35
    v_max3_u32 v38, v41, v55, v35
    v_min3_u32 v41, v41, v55, v35
    s_waitcnt lgkmcnt(0)
    v_med3_u32 v55, v42, v53, v52
    v_max3_u32 v35, v42, v53, v52
    v_min3_u32 v42, v42, v53, v52
    v_med3_u32 v53, v49, v51, v44
    v_max3_u32 v52, v49, v51, v44
    v_min3_u32 v49, v49, v51, v44
    v_med3_u32 v51, v47, v48, v46
    v_max3_u32 v44, v47, v48, v46
    v_min3_u32 v47, v47, v48, v46
    v_med3_u32 v48, v43, v45, v50
    v_max3_u32 v46, v43, v45, v50
    v_min3_u32 v43, v43, v45, v50
    v_med3_u32 v45, v53, v54, v55
    v_max3_u32 v50, v53, v54, v55
    v_min3_u32 v53, v53, v54, v55
    v_med3_u32 v54, v51, v45, v48
    v_max3_u32 v55, v51, v45, v48
    v_min3_u32 v51, v51, v45, v48
    v_med3_u32 v45, v42, v47, v43
    v_max3_u32 v48, v42, v47, v43
    v_min3_u32 v42, v42, v47, v43
    v_med3_u32 v47, v49, v53, v48
    v_max3_u32 v43, v49, v53, v48
    v_min3_u32 v49, v49, v53, v48
    v_med3_u32 v53, v45, v47, v51
    v_max3_u32 v48, v45, v47, v51
    v_min3_u32 v45, v45, v47, v51
    v_med3_u32 v47, v42, v49, v45
    v_max3_u32 v51, v42, v49, v45
    v_min3_u32 v42, v42, v49, v45
    v_lshl_add_u32 v64, v42, 8, v7
    buffer_load_dwordx4 v[64:67], v64, s[12:15], 0 offen
    v_lshl_add_u32 v68, v47, 8, v7
    buffer_load_dwordx4 v[68:71], v68, s[12:15], 0 offen
    v_med3_u32 v49, v52, v35, v44
    v_max3_u32 v45, v52, v35, v44
    v_min3_u32 v52, v52, v35, v44
    v_med3_u32 v35, v52, v50, v46
    v_max3_u32 v44, v52, v50, v46
    v_min3_u32 v52, v52, v50, v46
    v_med3_u32 v50, v43, v54, v52
    v_max3_u32 v46, v43, v54, v52
    v_min3_u32 v43, v43, v54, v52
    v_med3_u32 v54, v55, v35, v49
    v_max3_u32 v52, v55, v35, v49
    v_min3_u32 v55, v55, v35, v49
    s_mul_i32 s35, s22, 8
    s_add_u32 s35, s35, s34
    s_lshl_b32 s34, s35, 4
    s_load_dword s44, s[36:37], s34
    s_load_dword s45, s[28:29], 0x20000
    s_waitcnt vmcnt(3)
    v_mfma_f32_16x16x32_bf16 v[12:15], v[8:11], v[56:59], 0
    v_lshlrev_b32 v2, 16, v56
    v_and_b32 v3, s20, v56
    v_lshlrev_b32 v4, 16, v57
    v_and_b32 v5, s20, v57
    v_pk_mul_f32 v[2:3], v[2:3], v[2:3]
    v_pk_mul_f32 v[4:5], v[4:5], v[4:5]
    v_cvt_pk_bf16_f32 v56, v2, v3
    v_cvt_pk_bf16_f32 v57, v4, v5
    v_lshlrev_b32 v2, 16, v58
    v_and_b32 v3, s20, v58
    v_lshlrev_b32 v4, 16, v59
    v_and_b32 v5, s20, v59
    v_pk_mul_f32 v[2:3], v[2:3], v[2:3]
    v_pk_mul_f32 v[4:5], v[4:5], v[4:5]
    v_cvt_pk_bf16_f32 v58, v2, v3
    v_cvt_pk_bf16_f32 v59, v4, v5
    s_waitcnt vmcnt(2)
    v_mfma_f32_16x16x32_bf16 v[12:15], v[8:11], v[60:63], v[12:15]
    v_mfma_f32_16x16x32_bf16 v[16:19], v[8:11], v[56:59], 0
    v_lshl_add_u32 v56, v37, 8, v7
    buffer_load_dwordx4 v[56:59], v56, s[12:15], 0 offen
    v_lshlrev_b32 v2, 16, v60
    v_and_b32 v3, s20, v60
    v_lshlrev_b32 v4, 16, v61
    v_and_b32 v5, s20, v61
    v_pk_mul_f32 v[2:3], v[2:3], v[2:3]
    v_pk_mul_f32 v[4:5], v[4:5], v[4:5]
    v_cvt_pk_bf16_f32 v60, v2, v3
    v_cvt_pk_bf16_f32 v61, v4, v5
    v_lshlrev_b32 v2, 16, v62
    v_and_b32 v3, s20, v62
    v_lshlrev_b32 v4, 16, v63
    v_and_b32 v5, s20, v63
    v_pk_mul_f32 v[2:3], v[2:3], v[2:3]
    v_pk_mul_f32 v[4:5], v[4:5], v[4:5]
    v_cvt_pk_bf16_f32 v62, v2, v3
    v_cvt_pk_bf16_f32 v63, v4, v5
    s_waitcnt vmcnt(2)
    v_mfma_f32_16x16x32_bf16 v[20:23], v[8:11], v[64:67], 0
    v_mfma_f32_16x16x32_bf16 v[16:19], v[8:11], v[60:63], v[16:19]
    v_lshl_add_u32 v60, v51, 8, v7
    buffer_load_dwordx4 v[60:63], v60, s[12:15], 0 offen
    v_lshlrev_b32 v2, 16, v64
    v_and_b32 v3, s20, v64
    v_lshlrev_b32 v4, 16, v65
    v_and_b32 v5, s20, v65
    v_pk_mul_f32 v[2:3], v[2:3], v[2:3]
    v_pk_mul_f32 v[4:5], v[4:5], v[4:5]
    v_cvt_pk_bf16_f32 v64, v2, v3
    v_cvt_pk_bf16_f32 v65, v4, v5
    v_lshlrev_b32 v2, 16, v66
    v_and_b32 v3, s20, v66
    v_lshlrev_b32 v4, 16, v67
    v_and_b32 v5, s20, v67
    v_pk_mul_f32 v[2:3], v[2:3], v[2:3]
    v_pk_mul_f32 v[4:5], v[4:5], v[4:5]
    v_cvt_pk_bf16_f32 v66, v2, v3
    v_cvt_pk_bf16_f32 v67, v4, v5
    s_waitcnt vmcnt(2)
    v_mfma_f32_16x16x32_bf16 v[20:23], v[8:11], v[68:71], v[20:23]
    v_mfma_f32_16x16x32_bf16 v[24:27], v[8:11], v[64:67], 0
    v_lshl_add_u32 v64, v39, 8, v7
    buffer_load_dwordx4 v[64:67], v64, s[12:15], 0 offen
    v_lshlrev_b32 v2, 16, v68
    v_and_b32 v3, s20, v68
    v_lshlrev_b32 v4, 16, v69
    v_and_b32 v5, s20, v69
    v_pk_mul_f32 v[2:3], v[2:3], v[2:3]
    v_pk_mul_f32 v[4:5], v[4:5], v[4:5]
    v_cvt_pk_bf16_f32 v68, v2, v3
    v_cvt_pk_bf16_f32 v69, v4, v5
    v_lshlrev_b32 v2, 16, v70
    v_and_b32 v3, s20, v70
    v_lshlrev_b32 v4, 16, v71
    v_and_b32 v5, s20, v71
    v_pk_mul_f32 v[2:3], v[2:3], v[2:3]
    v_pk_mul_f32 v[4:5], v[4:5], v[4:5]
    v_cvt_pk_bf16_f32 v70, v2, v3
    v_cvt_pk_bf16_f32 v71, v4, v5
    s_barrier
    s_waitcnt vmcnt(2)
    v_mfma_f32_16x16x32_bf16 v[12:15], v[8:11], v[56:59], v[12:15]
    v_mfma_f32_16x16x32_bf16 v[24:27], v[8:11], v[68:71], v[24:27]
    v_lshl_add_u32 v68, v53, 8, v7
    buffer_load_dwordx4 v[68:71], v68, s[12:15], 0 offen
    v_lshlrev_b32 v2, 16, v56
    v_and_b32 v3, s20, v56
    v_lshlrev_b32 v4, 16, v57
    v_and_b32 v5, s20, v57
    v_pk_mul_f32 v[2:3], v[2:3], v[2:3]
    v_pk_mul_f32 v[4:5], v[4:5], v[4:5]
    v_cvt_pk_bf16_f32 v56, v2, v3
    v_cvt_pk_bf16_f32 v57, v4, v5
    v_lshlrev_b32 v2, 16, v58
    v_and_b32 v3, s20, v58
    v_lshlrev_b32 v4, 16, v59
    v_and_b32 v5, s20, v59
    v_pk_mul_f32 v[2:3], v[2:3], v[2:3]
    v_pk_mul_f32 v[4:5], v[4:5], v[4:5]
    v_cvt_pk_bf16_f32 v58, v2, v3
    v_cvt_pk_bf16_f32 v59, v4, v5
    s_waitcnt vmcnt(2)
    v_mfma_f32_16x16x32_bf16 v[20:23], v[8:11], v[60:63], v[20:23]
    v_mfma_f32_16x16x32_bf16 v[16:19], v[8:11], v[56:59], v[16:19]
    v_lshl_add_u32 v56, v34, 8, v7
    buffer_load_dwordx4 v[56:59], v56, s[12:15], 0 offen
    v_lshlrev_b32 v2, 16, v60
    v_and_b32 v3, s20, v60
    v_lshlrev_b32 v4, 16, v61
    v_and_b32 v5, s20, v61
    v_pk_mul_f32 v[2:3], v[2:3], v[2:3]
    v_pk_mul_f32 v[4:5], v[4:5], v[4:5]
    v_cvt_pk_bf16_f32 v60, v2, v3
    v_cvt_pk_bf16_f32 v61, v4, v5
    v_lshlrev_b32 v2, 16, v62
    v_and_b32 v3, s20, v62
    v_lshlrev_b32 v4, 16, v63
    v_and_b32 v5, s20, v63
    v_pk_mul_f32 v[2:3], v[2:3], v[2:3]
    v_pk_mul_f32 v[4:5], v[4:5], v[4:5]
    v_cvt_pk_bf16_f32 v62, v2, v3
    v_cvt_pk_bf16_f32 v63, v4, v5
    s_waitcnt vmcnt(2)
    v_mfma_f32_16x16x32_bf16 v[12:15], v[8:11], v[64:67], v[12:15]
    v_mfma_f32_16x16x32_bf16 v[24:27], v[8:11], v[60:63], v[24:27]
    v_lshl_add_u32 v60, v48, 8, v7
    buffer_load_dwordx4 v[60:63], v60, s[12:15], 0 offen
    v_lshlrev_b32 v2, 16, v64
    v_and_b32 v3, s20, v64
    v_lshlrev_b32 v4, 16, v65
    v_and_b32 v5, s20, v65
    v_pk_mul_f32 v[2:3], v[2:3], v[2:3]
    v_pk_mul_f32 v[4:5], v[4:5], v[4:5]
    v_cvt_pk_bf16_f32 v64, v2, v3
    v_cvt_pk_bf16_f32 v65, v4, v5
    v_lshlrev_b32 v2, 16, v66
    v_and_b32 v3, s20, v66
    v_lshlrev_b32 v4, 16, v67
    v_and_b32 v5, s20, v67
    v_pk_mul_f32 v[2:3], v[2:3], v[2:3]
    v_pk_mul_f32 v[4:5], v[4:5], v[4:5]
    v_cvt_pk_bf16_f32 v66, v2, v3
    v_cvt_pk_bf16_f32 v67, v4, v5
    s_waitcnt vmcnt(2)
    v_mfma_f32_16x16x32_bf16 v[20:23], v[8:11], v[68:71], v[20:23]
    v_mfma_f32_16x16x32_bf16 v[16:19], v[8:11], v[64:67], v[16:19]
    v_lshl_add_u32 v64, v29, 8, v7
    buffer_load_dwordx4 v[64:67], v64, s[12:15], 0 offen
    v_lshlrev_b32 v2, 16, v68
    v_and_b32 v3, s20, v68
    v_lshlrev_b32 v4, 16, v69
    v_and_b32 v5, s20, v69
    v_pk_mul_f32 v[2:3], v[2:3], v[2:3]
    v_pk_mul_f32 v[4:5], v[4:5], v[4:5]
    v_cvt_pk_bf16_f32 v68, v2, v3
    v_cvt_pk_bf16_f32 v69, v4, v5
    v_lshlrev_b32 v2, 16, v70
    v_and_b32 v3, s20, v70
    v_lshlrev_b32 v4, 16, v71
    v_and_b32 v5, s20, v71
    v_pk_mul_f32 v[2:3], v[2:3], v[2:3]
    v_pk_mul_f32 v[4:5], v[4:5], v[4:5]
    v_cvt_pk_bf16_f32 v70, v2, v3
    v_cvt_pk_bf16_f32 v71, v4, v5
    s_barrier
    s_waitcnt vmcnt(2)
    v_mfma_f32_16x16x32_bf16 v[12:15], v[8:11], v[56:59], v[12:15]
    v_mfma_f32_16x16x32_bf16 v[24:27], v[8:11], v[68:71], v[24:27]
    v_lshl_add_u32 v68, v43, 8, v7
    buffer_load_dwordx4 v[68:71], v68, s[12:15], 0 offen
    v_lshlrev_b32 v2, 16, v56
    v_and_b32 v3, s20, v56
    v_lshlrev_b32 v4, 16, v57
    v_and_b32 v5, s20, v57
    v_pk_mul_f32 v[2:3], v[2:3], v[2:3]
    v_pk_mul_f32 v[4:5], v[4:5], v[4:5]
    v_cvt_pk_bf16_f32 v56, v2, v3
    v_cvt_pk_bf16_f32 v57, v4, v5
    v_lshlrev_b32 v2, 16, v58
    v_and_b32 v3, s20, v58
    v_lshlrev_b32 v4, 16, v59
    v_and_b32 v5, s20, v59
    v_pk_mul_f32 v[2:3], v[2:3], v[2:3]
    v_pk_mul_f32 v[4:5], v[4:5], v[4:5]
    v_cvt_pk_bf16_f32 v58, v2, v3
    v_cvt_pk_bf16_f32 v59, v4, v5
    s_waitcnt vmcnt(2)
    v_mfma_f32_16x16x32_bf16 v[20:23], v[8:11], v[60:63], v[20:23]
    v_mfma_f32_16x16x32_bf16 v[16:19], v[8:11], v[56:59], v[16:19]
    v_lshl_add_u32 v56, v36, 8, v7
    buffer_load_dwordx4 v[56:59], v56, s[12:15], 0 offen
    v_lshlrev_b32 v2, 16, v60
    v_and_b32 v3, s20, v60
    v_lshlrev_b32 v4, 16, v61
    v_and_b32 v5, s20, v61
    v_pk_mul_f32 v[2:3], v[2:3], v[2:3]
    v_pk_mul_f32 v[4:5], v[4:5], v[4:5]
    v_cvt_pk_bf16_f32 v60, v2, v3
    v_cvt_pk_bf16_f32 v61, v4, v5
    v_lshlrev_b32 v2, 16, v62
    v_and_b32 v3, s20, v62
    v_lshlrev_b32 v4, 16, v63
    v_and_b32 v5, s20, v63
    v_pk_mul_f32 v[2:3], v[2:3], v[2:3]
    v_pk_mul_f32 v[4:5], v[4:5], v[4:5]
    v_cvt_pk_bf16_f32 v62, v2, v3
    v_cvt_pk_bf16_f32 v63, v4, v5
    s_waitcnt vmcnt(2)
    v_mfma_f32_16x16x32_bf16 v[12:15], v[8:11], v[64:67], v[12:15]
    v_mfma_f32_16x16x32_bf16 v[24:27], v[8:11], v[60:63], v[24:27]
    v_lshl_add_u32 v60, v50, 8, v7
    buffer_load_dwordx4 v[60:63], v60, s[12:15], 0 offen
    v_lshlrev_b32 v2, 16, v64
    v_and_b32 v3, s20, v64
    v_lshlrev_b32 v4, 16, v65
    v_and_b32 v5, s20, v65
    v_pk_mul_f32 v[2:3], v[2:3], v[2:3]
    v_pk_mul_f32 v[4:5], v[4:5], v[4:5]
    v_cvt_pk_bf16_f32 v64, v2, v3
    v_cvt_pk_bf16_f32 v65, v4, v5
    v_lshlrev_b32 v2, 16, v66
    v_and_b32 v3, s20, v66
    v_lshlrev_b32 v4, 16, v67
    v_and_b32 v5, s20, v67
    v_pk_mul_f32 v[2:3], v[2:3], v[2:3]
    v_pk_mul_f32 v[4:5], v[4:5], v[4:5]
    v_cvt_pk_bf16_f32 v66, v2, v3
    v_cvt_pk_bf16_f32 v67, v4, v5
    s_waitcnt vmcnt(2)
    v_mfma_f32_16x16x32_bf16 v[20:23], v[8:11], v[68:71], v[20:23]
    v_mfma_f32_16x16x32_bf16 v[16:19], v[8:11], v[64:67], v[16:19]
    v_lshl_add_u32 v64, v32, 8, v7
    buffer_load_dwordx4 v[64:67], v64, s[12:15], 0 offen
    v_lshlrev_b32 v2, 16, v68
    v_and_b32 v3, s20, v68
    v_lshlrev_b32 v4, 16, v69
    v_and_b32 v5, s20, v69
    v_pk_mul_f32 v[2:3], v[2:3], v[2:3]
    v_pk_mul_f32 v[4:5], v[4:5], v[4:5]
    v_cvt_pk_bf16_f32 v68, v2, v3
    v_cvt_pk_bf16_f32 v69, v4, v5
    v_lshlrev_b32 v2, 16, v70
    v_and_b32 v3, s20, v70
    v_lshlrev_b32 v4, 16, v71
    v_and_b32 v5, s20, v71
    v_pk_mul_f32 v[2:3], v[2:3], v[2:3]
    v_pk_mul_f32 v[4:5], v[4:5], v[4:5]
    v_cvt_pk_bf16_f32 v70, v2, v3
    v_cvt_pk_bf16_f32 v71, v4, v5
    s_barrier
    s_waitcnt vmcnt(2)
    v_mfma_f32_16x16x32_bf16 v[12:15], v[8:11], v[56:59], v[12:15]
    v_mfma_f32_16x16x32_bf16 v[24:27], v[8:11], v[68:71], v[24:27]
    v_lshl_add_u32 v68, v46, 8, v7
    buffer_load_dwordx4 v[68:71], v68, s[12:15], 0 offen
    v_lshlrev_b32 v2, 16, v56
    v_and_b32 v3, s20, v56
    v_lshlrev_b32 v4, 16, v57
    v_and_b32 v5, s20, v57
    v_pk_mul_f32 v[2:3], v[2:3], v[2:3]
    v_pk_mul_f32 v[4:5], v[4:5], v[4:5]
    v_cvt_pk_bf16_f32 v56, v2, v3
    v_cvt_pk_bf16_f32 v57, v4, v5
    v_lshlrev_b32 v2, 16, v58
    v_and_b32 v3, s20, v58
    v_lshlrev_b32 v4, 16, v59
    v_and_b32 v5, s20, v59
    v_pk_mul_f32 v[2:3], v[2:3], v[2:3]
    v_pk_mul_f32 v[4:5], v[4:5], v[4:5]
    v_cvt_pk_bf16_f32 v58, v2, v3
    v_cvt_pk_bf16_f32 v59, v4, v5
    s_waitcnt vmcnt(2)
    v_mfma_f32_16x16x32_bf16 v[20:23], v[8:11], v[60:63], v[20:23]
    v_mfma_f32_16x16x32_bf16 v[16:19], v[8:11], v[56:59], v[16:19]
    v_lshl_add_u32 v56, v41, 8, v7
    buffer_load_dwordx4 v[56:59], v56, s[12:15], 0 offen
    v_lshlrev_b32 v2, 16, v60
    v_and_b32 v3, s20, v60
    v_lshlrev_b32 v4, 16, v61
    v_and_b32 v5, s20, v61
    v_pk_mul_f32 v[2:3], v[2:3], v[2:3]
    v_pk_mul_f32 v[4:5], v[4:5], v[4:5]
    v_cvt_pk_bf16_f32 v60, v2, v3
    v_cvt_pk_bf16_f32 v61, v4, v5
    v_lshlrev_b32 v2, 16, v62
    v_and_b32 v3, s20, v62
    v_lshlrev_b32 v4, 16, v63
    v_and_b32 v5, s20, v63
    v_pk_mul_f32 v[2:3], v[2:3], v[2:3]
    v_pk_mul_f32 v[4:5], v[4:5], v[4:5]
    v_cvt_pk_bf16_f32 v62, v2, v3
    v_cvt_pk_bf16_f32 v63, v4, v5
    s_waitcnt vmcnt(2)
    v_mfma_f32_16x16x32_bf16 v[12:15], v[8:11], v[64:67], v[12:15]
    v_mfma_f32_16x16x32_bf16 v[24:27], v[8:11], v[60:63], v[24:27]
    v_lshl_add_u32 v60, v55, 8, v7
    buffer_load_dwordx4 v[60:63], v60, s[12:15], 0 offen
    v_lshlrev_b32 v2, 16, v64
    v_and_b32 v3, s20, v64
    v_lshlrev_b32 v4, 16, v65
    v_and_b32 v5, s20, v65
    v_pk_mul_f32 v[2:3], v[2:3], v[2:3]
    v_pk_mul_f32 v[4:5], v[4:5], v[4:5]
    v_cvt_pk_bf16_f32 v64, v2, v3
    v_cvt_pk_bf16_f32 v65, v4, v5
    v_lshlrev_b32 v2, 16, v66
    v_and_b32 v3, s20, v66
    v_lshlrev_b32 v4, 16, v67
    v_and_b32 v5, s20, v67
    v_pk_mul_f32 v[2:3], v[2:3], v[2:3]
    v_pk_mul_f32 v[4:5], v[4:5], v[4:5]
    v_cvt_pk_bf16_f32 v66, v2, v3
    v_cvt_pk_bf16_f32 v67, v4, v5
    s_waitcnt vmcnt(2)
    v_mfma_f32_16x16x32_bf16 v[20:23], v[8:11], v[68:71], v[20:23]
    v_mfma_f32_16x16x32_bf16 v[16:19], v[8:11], v[64:67], v[16:19]
    v_lshl_add_u32 v64, v40, 8, v7
    buffer_load_dwordx4 v[64:67], v64, s[12:15], 0 offen
    v_lshlrev_b32 v2, 16, v68
    v_and_b32 v3, s20, v68
    v_lshlrev_b32 v4, 16, v69
    v_and_b32 v5, s20, v69
    v_pk_mul_f32 v[2:3], v[2:3], v[2:3]
    v_pk_mul_f32 v[4:5], v[4:5], v[4:5]
    v_cvt_pk_bf16_f32 v68, v2, v3
    v_cvt_pk_bf16_f32 v69, v4, v5
    v_lshlrev_b32 v2, 16, v70
    v_and_b32 v3, s20, v70
    v_lshlrev_b32 v4, 16, v71
    v_and_b32 v5, s20, v71
    v_pk_mul_f32 v[2:3], v[2:3], v[2:3]
    v_pk_mul_f32 v[4:5], v[4:5], v[4:5]
    v_cvt_pk_bf16_f32 v70, v2, v3
    v_cvt_pk_bf16_f32 v71, v4, v5
    s_barrier
    s_waitcnt vmcnt(2)
    v_mfma_f32_16x16x32_bf16 v[12:15], v[8:11], v[56:59], v[12:15]
    v_mfma_f32_16x16x32_bf16 v[24:27], v[8:11], v[68:71], v[24:27]
    v_lshl_add_u32 v68, v54, 8, v7
    buffer_load_dwordx4 v[68:71], v68, s[12:15], 0 offen
    v_lshlrev_b32 v2, 16, v56
    v_and_b32 v3, s20, v56
    v_lshlrev_b32 v4, 16, v57
    v_and_b32 v5, s20, v57
    v_pk_mul_f32 v[2:3], v[2:3], v[2:3]
    v_pk_mul_f32 v[4:5], v[4:5], v[4:5]
    v_cvt_pk_bf16_f32 v56, v2, v3
    v_cvt_pk_bf16_f32 v57, v4, v5
    v_lshlrev_b32 v2, 16, v58
    v_and_b32 v3, s20, v58
    v_lshlrev_b32 v4, 16, v59
    v_and_b32 v5, s20, v59
    v_pk_mul_f32 v[2:3], v[2:3], v[2:3]
    v_pk_mul_f32 v[4:5], v[4:5], v[4:5]
    v_cvt_pk_bf16_f32 v58, v2, v3
    v_cvt_pk_bf16_f32 v59, v4, v5
    s_waitcnt vmcnt(2)
    v_mfma_f32_16x16x32_bf16 v[20:23], v[8:11], v[60:63], v[20:23]
    v_mfma_f32_16x16x32_bf16 v[16:19], v[8:11], v[56:59], v[16:19]
    v_lshl_add_u32 v56, v38, 8, v7
    buffer_load_dwordx4 v[56:59], v56, s[12:15], 0 offen
    v_lshlrev_b32 v2, 16, v60
    v_and_b32 v3, s20, v60
    v_lshlrev_b32 v4, 16, v61
    v_and_b32 v5, s20, v61
    v_pk_mul_f32 v[2:3], v[2:3], v[2:3]
    v_pk_mul_f32 v[4:5], v[4:5], v[4:5]
    v_cvt_pk_bf16_f32 v60, v2, v3
    v_cvt_pk_bf16_f32 v61, v4, v5
    v_lshlrev_b32 v2, 16, v62
    v_and_b32 v3, s20, v62
    v_lshlrev_b32 v4, 16, v63
    v_and_b32 v5, s20, v63
    v_pk_mul_f32 v[2:3], v[2:3], v[2:3]
    v_pk_mul_f32 v[4:5], v[4:5], v[4:5]
    v_cvt_pk_bf16_f32 v62, v2, v3
    v_cvt_pk_bf16_f32 v63, v4, v5
    s_waitcnt vmcnt(2)
    v_mfma_f32_16x16x32_bf16 v[12:15], v[8:11], v[64:67], v[12:15]
    v_mfma_f32_16x16x32_bf16 v[24:27], v[8:11], v[60:63], v[24:27]
    v_lshl_add_u32 v60, v52, 8, v7
    buffer_load_dwordx4 v[60:63], v60, s[12:15], 0 offen
    v_lshlrev_b32 v2, 16, v64
    v_and_b32 v3, s20, v64
    v_lshlrev_b32 v4, 16, v65
    v_and_b32 v5, s20, v65
    v_pk_mul_f32 v[2:3], v[2:3], v[2:3]
    v_pk_mul_f32 v[4:5], v[4:5], v[4:5]
    v_cvt_pk_bf16_f32 v64, v2, v3
    v_cvt_pk_bf16_f32 v65, v4, v5
    v_lshlrev_b32 v2, 16, v66
    v_and_b32 v3, s20, v66
    v_lshlrev_b32 v4, 16, v67
    v_and_b32 v5, s20, v67
    v_pk_mul_f32 v[2:3], v[2:3], v[2:3]
    v_pk_mul_f32 v[4:5], v[4:5], v[4:5]
    v_cvt_pk_bf16_f32 v66, v2, v3
    v_cvt_pk_bf16_f32 v67, v4, v5
    s_waitcnt vmcnt(2)
    v_mfma_f32_16x16x32_bf16 v[20:23], v[8:11], v[68:71], v[20:23]
    v_mfma_f32_16x16x32_bf16 v[16:19], v[8:11], v[64:67], v[16:19]
    v_lshl_add_u32 v64, v30, 8, v7
    buffer_load_dwordx4 v[64:67], v64, s[12:15], 0 offen
    v_lshlrev_b32 v2, 16, v68
    v_and_b32 v3, s20, v68
    v_lshlrev_b32 v4, 16, v69
    v_and_b32 v5, s20, v69
    v_pk_mul_f32 v[2:3], v[2:3], v[2:3]
    v_pk_mul_f32 v[4:5], v[4:5], v[4:5]
    v_cvt_pk_bf16_f32 v68, v2, v3
    v_cvt_pk_bf16_f32 v69, v4, v5
    v_lshlrev_b32 v2, 16, v70
    v_and_b32 v3, s20, v70
    v_lshlrev_b32 v4, 16, v71
    v_and_b32 v5, s20, v71
    v_pk_mul_f32 v[2:3], v[2:3], v[2:3]
    v_pk_mul_f32 v[4:5], v[4:5], v[4:5]
    v_cvt_pk_bf16_f32 v70, v2, v3
    v_cvt_pk_bf16_f32 v71, v4, v5
    s_barrier
    s_waitcnt vmcnt(2)
    v_mfma_f32_16x16x32_bf16 v[12:15], v[8:11], v[56:59], v[12:15]
    v_mfma_f32_16x16x32_bf16 v[24:27], v[8:11], v[68:71], v[24:27]
    v_lshl_add_u32 v68, v44, 8, v7
    buffer_load_dwordx4 v[68:71], v68, s[12:15], 0 offen
    v_lshlrev_b32 v2, 16, v56
    v_and_b32 v3, s20, v56
    v_lshlrev_b32 v4, 16, v57
    v_and_b32 v5, s20, v57
    v_pk_mul_f32 v[2:3], v[2:3], v[2:3]
    v_pk_mul_f32 v[4:5], v[4:5], v[4:5]
    v_cvt_pk_bf16_f32 v56, v2, v3
    v_cvt_pk_bf16_f32 v57, v4, v5
    v_lshlrev_b32 v2, 16, v58
    v_and_b32 v3, s20, v58
    v_lshlrev_b32 v4, 16, v59
    v_and_b32 v5, s20, v59
    v_pk_mul_f32 v[2:3], v[2:3], v[2:3]
    v_pk_mul_f32 v[4:5], v[4:5], v[4:5]
    v_cvt_pk_bf16_f32 v58, v2, v3
    v_cvt_pk_bf16_f32 v59, v4, v5
    s_waitcnt vmcnt(2)
    v_mfma_f32_16x16x32_bf16 v[20:23], v[8:11], v[60:63], v[20:23]
    v_mfma_f32_16x16x32_bf16 v[16:19], v[8:11], v[56:59], v[16:19]
    v_lshl_add_u32 v56, v31, 8, v7
    buffer_load_dwordx4 v[56:59], v56, s[12:15], 0 offen
    v_lshlrev_b32 v2, 16, v60
    v_and_b32 v3, s20, v60
    v_lshlrev_b32 v4, 16, v61
    v_and_b32 v5, s20, v61
    v_pk_mul_f32 v[2:3], v[2:3], v[2:3]
    v_pk_mul_f32 v[4:5], v[4:5], v[4:5]
    v_cvt_pk_bf16_f32 v60, v2, v3
    v_cvt_pk_bf16_f32 v61, v4, v5
    v_lshlrev_b32 v2, 16, v62
    v_and_b32 v3, s20, v62
    v_lshlrev_b32 v4, 16, v63
    v_and_b32 v5, s20, v63
    v_pk_mul_f32 v[2:3], v[2:3], v[2:3]
    v_pk_mul_f32 v[4:5], v[4:5], v[4:5]
    v_cvt_pk_bf16_f32 v62, v2, v3
    v_cvt_pk_bf16_f32 v63, v4, v5
    s_waitcnt vmcnt(2)
    v_mfma_f32_16x16x32_bf16 v[12:15], v[8:11], v[64:67], v[12:15]
    v_mfma_f32_16x16x32_bf16 v[24:27], v[8:11], v[60:63], v[24:27]
    v_lshl_add_u32 v60, v45, 8, v7
    buffer_load_dwordx4 v[60:63], v60, s[12:15], 0 offen
    v_lshlrev_b32 v2, 16, v64
    v_and_b32 v3, s20, v64
    v_lshlrev_b32 v4, 16, v65
    v_and_b32 v5, s20, v65
    v_pk_mul_f32 v[2:3], v[2:3], v[2:3]
    v_pk_mul_f32 v[4:5], v[4:5], v[4:5]
    v_cvt_pk_bf16_f32 v64, v2, v3
    v_cvt_pk_bf16_f32 v65, v4, v5
    v_lshlrev_b32 v2, 16, v66
    v_and_b32 v3, s20, v66
    v_lshlrev_b32 v4, 16, v67
    v_and_b32 v5, s20, v67
    v_pk_mul_f32 v[2:3], v[2:3], v[2:3]
    v_pk_mul_f32 v[4:5], v[4:5], v[4:5]
    v_cvt_pk_bf16_f32 v66, v2, v3
    v_cvt_pk_bf16_f32 v67, v4, v5
    s_waitcnt vmcnt(2)
    v_mfma_f32_16x16x32_bf16 v[20:23], v[8:11], v[68:71], v[20:23]
    v_mfma_f32_16x16x32_bf16 v[16:19], v[8:11], v[64:67], v[16:19]
    buffer_load_dword v6, v6, s[24:27], 0 offen sc1
    v_lshlrev_b32 v2, 16, v68
    v_and_b32 v3, s20, v68
    v_lshlrev_b32 v4, 16, v69
    v_and_b32 v5, s20, v69
    v_pk_mul_f32 v[2:3], v[2:3], v[2:3]
    v_pk_mul_f32 v[4:5], v[4:5], v[4:5]
    v_cvt_pk_bf16_f32 v68, v2, v3
    v_cvt_pk_bf16_f32 v69, v4, v5
    v_lshlrev_b32 v2, 16, v70
    v_and_b32 v3, s20, v70
    v_lshlrev_b32 v4, 16, v71
    v_and_b32 v5, s20, v71
    v_pk_mul_f32 v[2:3], v[2:3], v[2:3]
    v_pk_mul_f32 v[4:5], v[4:5], v[4:5]
    v_cvt_pk_bf16_f32 v70, v2, v3
    v_cvt_pk_bf16_f32 v71, v4, v5
    v_and_b32 v36, 15, v0
    v_bfe_u32 v37, v0, 5, 1
    v_mov_b32 v38, 0x3f803f80
    v_cmp_eq_u32 vcc, v36, v37
    v_add_u32 v37, 2, v37
    s_nop 0
    v_cndmask_b32 v28, 0, v38, vcc
    v_cndmask_b32 v29, 0, v38, vcc
    v_cmp_eq_u32 vcc, v36, v37
    v_lshlrev_b32 v36, 3, v1
    v_lshlrev_b32 v1, 1, v1
    v_cndmask_b32 v30, 0, v38, vcc
    v_cndmask_b32 v31, 0, v38, vcc
    s_waitcnt vmcnt(2)
    v_mfma_f32_16x16x32_bf16 v[12:15], v[8:11], v[56:59], v[12:15]
    v_mfma_f32_16x16x32_bf16 v[24:27], v[8:11], v[68:71], v[24:27]
    v_lshlrev_b32 v2, 16, v56
    v_and_b32 v3, s20, v56
    v_lshlrev_b32 v4, 16, v57
    v_and_b32 v5, s20, v57
    v_pk_mul_f32 v[2:3], v[2:3], v[2:3]
    v_pk_mul_f32 v[4:5], v[4:5], v[4:5]
    v_cvt_pk_bf16_f32 v56, v2, v3
    v_cvt_pk_bf16_f32 v57, v4, v5
    v_lshlrev_b32 v2, 16, v58
    v_and_b32 v3, s20, v58
    v_lshlrev_b32 v4, 16, v59
    v_and_b32 v5, s20, v59
    v_pk_mul_f32 v[2:3], v[2:3], v[2:3]
    v_pk_mul_f32 v[4:5], v[4:5], v[4:5]
    v_cvt_pk_bf16_f32 v58, v2, v3
    v_cvt_pk_bf16_f32 v59, v4, v5
    s_waitcnt vmcnt(1)
    v_mfma_f32_16x16x32_bf16 v[20:23], v[8:11], v[60:63], v[20:23]
    v_mfma_f32_16x16x32_bf16 v[16:19], v[8:11], v[56:59], v[16:19]
    v_lshlrev_b32 v2, 16, v60
    v_and_b32 v3, s20, v60
    v_lshlrev_b32 v4, 16, v61
    v_and_b32 v5, s20, v61
    v_pk_mul_f32 v[2:3], v[2:3], v[2:3]
    v_pk_mul_f32 v[4:5], v[4:5], v[4:5]
    v_cvt_pk_bf16_f32 v60, v2, v3
    v_cvt_pk_bf16_f32 v61, v4, v5
    v_lshlrev_b32 v2, 16, v62
    v_and_b32 v3, s20, v62
    v_lshlrev_b32 v4, 16, v63
    v_and_b32 v5, s20, v63
    v_pk_mul_f32 v[2:3], v[2:3], v[2:3]
    v_pk_mul_f32 v[4:5], v[4:5], v[4:5]
    v_cvt_pk_bf16_f32 v62, v2, v3
    v_cvt_pk_bf16_f32 v63, v4, v5
    s_nop 1
    v_mfma_f32_16x16x32_bf16 v[24:27], v[8:11], v[60:63], v[24:27]
    v_cvt_pk_bf16_f32 v2, v12, v13
    v_cvt_pk_bf16_f32 v3, v14, v15
    v_lshlrev_b32 v12, 16, v2
    v_and_b32 v13, s20, v2
    v_lshlrev_b32 v14, 16, v3
    v_and_b32 v15, s20, v3
    v_pk_mul_f32 v[12:13], v[12:13], v[12:13]
    v_pk_mul_f32 v[14:15], v[14:15], v[14:15]
    v_cvt_pk_bf16_f32 v2, v12, v13
    v_cvt_pk_bf16_f32 v3, v14, v15
    v_cvt_pk_bf16_f32 v4, v16, v17
    v_cvt_pk_bf16_f32 v5, v18, v19
    v_lshlrev_b32 v12, 16, v2
    v_and_b32 v13, s20, v2
    v_lshlrev_b32 v14, 16, v3
    v_and_b32 v15, s20, v3
    v_lshlrev_b32 v16, 16, v4
    v_and_b32 v17, s20, v4
    v_lshlrev_b32 v18, 16, v5
    v_and_b32 v19, s20, v5
    v_pk_add_f32 v[12:13], v[12:13], v[16:17] neg_lo:[0,1] neg_hi:[0,1]
    v_pk_add_f32 v[14:15], v[14:15], v[18:19] neg_lo:[0,1] neg_hi:[0,1]
    v_cvt_pk_bf16_f32 v32, v12, v13
    v_cvt_pk_bf16_f32 v33, v14, v15
    v_cvt_pk_bf16_f32 v2, v20, v21
    v_cvt_pk_bf16_f32 v3, v22, v23
    v_lshlrev_b32 v20, 16, v2
    v_and_b32 v21, s20, v2
    v_lshlrev_b32 v22, 16, v3
    v_and_b32 v23, s20, v3
    v_pk_mul_f32 v[20:21], v[20:21], v[20:21]
    v_pk_mul_f32 v[22:23], v[22:23], v[22:23]
    v_cvt_pk_bf16_f32 v2, v20, v21
    v_cvt_pk_bf16_f32 v3, v22, v23
    v_cvt_pk_bf16_f32 v4, v24, v25
    v_cvt_pk_bf16_f32 v5, v26, v27
    v_lshlrev_b32 v20, 16, v2
    v_and_b32 v21, s20, v2
    v_lshlrev_b32 v22, 16, v3
    v_and_b32 v23, s20, v3
    v_lshlrev_b32 v24, 16, v4
    v_and_b32 v25, s20, v4
    v_lshlrev_b32 v26, 16, v5
    v_and_b32 v27, s20, v5
    v_pk_add_f32 v[20:21], v[20:21], v[24:25] neg_lo:[0,1] neg_hi:[0,1]
    v_pk_add_f32 v[22:23], v[22:23], v[26:27] neg_lo:[0,1] neg_hi:[0,1]
    v_cvt_pk_bf16_f32 v34, v20, v21
    v_cvt_pk_bf16_f32 v35, v22, v23
    s_waitcnt vmcnt(0)
    v_cmp_eq_u32 vcc, 0, v6
    v_mfma_f32_16x16x32_bf16 v[12:15], v[32:35], v[28:31], 0
    s_cmp_lg_u64 vcc, 0
    s_cbranch_scc1 L_slow
L_go:
    v_mov_b32 v4, 0x7fc00000
    s_nop 4
    v_pk_add_f32 v[12:13], v[12:13], v[14:15]
    v_add_f32 v12, v12, v13
    v_mov_b32 v13, v12
    s_nop 1
    v_permlane16_swap_b32 v12, v13
    v_add_f32 v12, v12, v13
    v_cmp_u_f32 vcc, v12, v12
    s_mov_b32 exec_lo, 0x0000000f
    s_mov_b32 exec_hi, 0x0000000f
    v_cndmask_b32 v12, v12, v4, vcc
    v_cndmask_b32 v2, v12, -1, s[32:33]
    v_cndmask_b32 v3, -1, v12, s[32:33]
    buffer_atomic_and_x2 v[2:3], v36, s[28:31], 0 offen sc0 sc1
    s_waitcnt vmcnt(0)
    v_cndmask_b32 v2, v3, v2, s[32:33]
    v_cmp_ne_u32 vcc, -1, v2
    v_add_f32 v2, v2, v12
    v_mul_f32 v2, 0.5, v2
    v_cvt_pk_bf16_f32 v2, v2, v2
    s_and_b64 exec, exec, vcc
    s_cbranch_execz L_fin
    buffer_store_short v2, v1, s[16:19], 0 offen
L_fin:
L_end:
    s_endpgm
L_slow:
    v_lshrrev_b32 v5, 9, v1
    v_lshlrev_b32 v5, 2, v5
    s_mov_b32 s3, 0
L_poll:
    s_sleep 32
    s_add_u32 s3, s3, 1
    s_mov_b64 exec, 1
    s_and_b32 s35, s3, 7
    s_cbranch_scc0 L_poll_rmw
    buffer_load_dword v6, v5, s[24:27], 0 offen sc0 sc1
    s_branch L_poll_chk
L_poll_rmw:
    v_mov_b32 v6, 0
    buffer_atomic_or v6, v5, s[24:27], 0 offen sc0 sc1
L_poll_chk:
    s_waitcnt vmcnt(0)
    v_cmp_eq_u32 vcc, 0, v6
    s_mov_b64 exec, -1
    s_cmp_lg_u64 vcc, 0
    s_cbranch_scc1 L_poll
    s_branch L_go
L_helper:
    s_load_dwordx2 s[24:25], s[0:1], 24
    s_load_dwordx2 s[28:29], s[0:1], 32
    v_lshrrev_b32 v5, 6, v0
    v_and_b32 v1, 63, v0
    v_readfirstlane_b32 s34, v5
    v_mov_b32 v8, -1
    v_mov_b32 v9, -1
    v_mov_b32 v10, -1
    v_mov_b32 v11, -1
    s_cmp_ge_u32 s34, 8
    s_cbranch_scc1 L_end
    s_lshl_b32 s3, s2, 3
    s_add_u32 s3, s3, s34
    s_mul_i32 s35, s3, 2048
    v_lshlrev_b32 v2, 4, v1
    v_add_u32 v2, s35, v2
    s_lshl_b32 s3, s3, 2
    v_mov_b32 v3, s3
    v_mov_b32 v4, 1
    s_mov_b32 s30, 131072
    s_mov_b32 s31, 0x00020000
    s_mov_b32 s26, 256
    s_mov_b32 s27, 0x00020000
    s_waitcnt lgkmcnt(0)
    s_and_b32 s29, s29, 0xffff
    s_and_b32 s25, s25, 0xffff
    buffer_store_dwordx4 v[8:11], v2, s[28:31], 0 offen offset:0 sc1
    buffer_store_dwordx4 v[8:11], v2, s[28:31], 0 offen offset:1024 sc1
    s_mov_b64 exec, 1
    s_waitcnt vmcnt(0)
    buffer_store_dword v4, v3, s[24:27], 0 offen sc1
    s_endpgm
.section .rodata,"a"
.p2align 6
.amdhsa_kernel standalone__fm_second_order__recsys_kernel
  .amdhsa_next_free_vgpr 72
  .amdhsa_next_free_sgpr 48
  .amdhsa_accum_offset 72
  .amdhsa_group_segment_fixed_size 0
  .amdhsa_kernarg_size 40
  .amdhsa_user_sgpr_count 2
  .amdhsa_user_sgpr_kernarg_segment_ptr 1
  .amdhsa_system_sgpr_workgroup_id_x 1
  .amdhsa_float_denorm_mode_32 3
.end_amdhsa_kernel
```
